```python
import torch

def _softmax(x, axis=-1):
    return torch.softmax(x, dim=axis)
def _gelu(x):
    return torch.nn.functional.gelu(x, approximate="tanh")
def _silu(x):
    return torch.nn.functional.silu(x)
def _sigmoid(x):
    return torch.sigmoid(x)
def _layernorm(x, axis=-1, eps=1e-5):
    m = x.mean(dim=axis, keepdim=True)
    v = x.var(dim=axis, keepdim=True, unbiased=False)
    return (x - m) / torch.sqrt(v + eps)
def _scatter_add(tgt, idx, src, axis=0):
    return tgt.clone().index_add_(axis, idx, src)
def _segment_sum(src, seg, n):
    out = torch.zeros((n,) + src.shape[1:], dtype=src.dtype)
    return out.index_add_(0, seg, src)
def _pad(x, pw):
    flat = tuple(v for pair in reversed(pw) for v in pair)
    return torch.nn.functional.pad(x, flat)

kernel_name = 'standalone__gqa_block_cached__sampling'

def setup_inputs():

    _w = (lambda a: (lambda t: t.to(torch.bfloat16) if t.is_floating_point() else t)(torch.as_tensor(a)))
    B, Sq, D = 8, 4, 512
    Hq, Hkv, Sk, Dh = 32, 8, 4096, 128
    assert Hq % Hkv == 0, (Hq, Hkv)
    return {
        "x": _w((lambda *s: torch.randn(*s, dtype=torch.bfloat16) * 0.8)(B, Sq, D)),
        "k_cache": _w((lambda *s: torch.randn(*s, dtype=torch.bfloat16) * 0.8)(B, Hkv, Sk, Dh)),
        "v_cache": _w((lambda *s: torch.randn(*s, dtype=torch.bfloat16) * 0.05)(B, Hkv, Sk, Dh)),
        "wq": _w((lambda *s: torch.randn(*s, dtype=torch.bfloat16) * 0.8)(D, Hq * Dh) * (D ** -0.5)),
        "wo": _w((lambda *s: torch.randn(*s, dtype=torch.bfloat16) * 0.05)(Hq * Dh, D) * ((Hq * Dh) ** -0.5)),
    }

def reference(x, k_cache, v_cache, wq, wo):
    B, Sq, D = x.shape
    Hq, Dh = 32, 128
    Hkv = k_cache.shape[1]
    rep = Hq // Hkv
    q = (lambda x, *d: x.permute(*d))((x @ wq).reshape(B, Sq, Hq, Dh), 0, 2, 1, 3)
    k = (lambda x, n, axis: torch.repeat_interleave(x, n, dim=axis))(k_cache, rep, axis=1)
    v = (lambda x, n, axis: torch.repeat_interleave(x, n, dim=axis))(v_cache, rep, axis=1)
    scores = torch.einsum("bhqd,bhkd->bhqk", q, k) * (Dh ** -0.5)
    p = _softmax(scores, axis=-1)
    o = torch.einsum("bhqk,bhkd->bhqd", p, v)
    return (lambda x, *d: x.permute(*d))(o, 0, 2, 1, 3).reshape(B, Sq, Hq * Dh) @ wo
```

```asm
; @launch kernel=qproj_kernel grid=(256,1,1) block=(512,1,1) lds=32768
; @launch kernel=standalone__gqa_block_cached__sampling_kernel grid=(256,1,1) block=(512,1,1) lds=163840
.amdgcn_target "amdgcn-amd-amdhsa--gfx950"
.text
.globl qproj_kernel
.p2align 8
.type qproj_kernel,@function
qproj_kernel:
    s_load_dwordx16 s[4:19], s[0:1], 0
    s_cmp_ge_u32 s2, 256
    s_cbranch_scc1 L_END1
    s_lshr_b32 s52, s2, 5
    s_lshr_b32 s53, s2, 2
    s_and_b32 s53, s53, 7
    s_and_b32 s54, s2, 3
    v_and_b32 v1, 63, v0
    v_lshrrev_b32 v2, 6, v0
    s_nop 0
    v_readfirstlane_b32 s55, v2
    s_lshl_b32 s56, s55, 14
    s_lshl_b32 s64, s52, 3
    s_add_u32 s64, s64, s53
    s_lshl_b32 s64, s64, 20
    s_lshl_b32 s65, s54, 18
    s_add_u32 s57, s64, s65
    s_mul_i32 s58, s2, 12288
    s_add_u32 s58, s58, 0x100000
    s_mov_b32 s60, 0x3e0293ee
    s_mov_b32 s61, 0xbe0293ee
    s_mov_b32 s62, 0x05040100
    s_mov_b32 s63, 0x07060302
    s_waitcnt lgkmcnt(0)
    s_mov_b32 s20, s4
    s_mov_b32 s21, s5
    s_mov_b32 s22, 0x8000
    s_mov_b32 s23, 0x00020000
    s_mov_b32 s24, s6
    s_mov_b32 s25, s7
    s_mov_b32 s26, 0x4000000
    s_mov_b32 s27, 0x00020000
    s_mov_b32 s28, s8
    s_mov_b32 s29, s9
    s_mov_b32 s30, 0x4000000
    s_mov_b32 s31, 0x00020000
    s_mov_b32 s32, s10
    s_mov_b32 s33, s11
    s_mov_b32 s34, 0x400000
    s_mov_b32 s35, 0x00020000
    s_mov_b32 s36, s12
    s_mov_b32 s37, s13
    s_mov_b32 s38, 0x400000
    s_mov_b32 s39, 0x00020000
    s_mov_b32 s40, s14
    s_mov_b32 s41, s15
    s_mov_b32 s42, 0x8000
    s_mov_b32 s43, 0x00020000
    s_mov_b32 s44, s16
    s_mov_b32 s45, s17
    s_mov_b32 s46, 0x100
    s_mov_b32 s47, 0x00020000
    s_mov_b32 s48, s18
    s_mov_b32 s49, s19
    s_mov_b32 s50, 0x10000000
    s_mov_b32 s51, 0x00020000
    v_and_b32 v2, 15, v1
    v_lshrrev_b32 v3, 4, v1
    v_lshlrev_b32 v4, 2, v3
    v_add_u32 v4, 0, v4
    v_xor_b32 v4, v4, v2
    v_lshlrev_b32 v4, 4, v4
    v_lshl_add_u32 v20, v3, 8, v4
    v_lshlrev_b32 v4, 2, v3
    v_add_u32 v4, 1, v4
    v_xor_b32 v4, v4, v2
    v_lshlrev_b32 v4, 4, v4
    v_lshl_add_u32 v21, v3, 8, v4
    v_lshlrev_b32 v4, 2, v3
    v_add_u32 v4, 2, v4
    v_xor_b32 v4, v4, v2
    v_lshlrev_b32 v4, 4, v4
    v_lshl_add_u32 v22, v3, 8, v4
    v_lshlrev_b32 v4, 2, v3
    v_add_u32 v4, 3, v4
    v_xor_b32 v4, v4, v2
    v_lshlrev_b32 v4, 4, v4
    v_lshl_add_u32 v23, v3, 8, v4
    v_and_b32 v4, 3, v2
    v_lshlrev_b32 v4, 2, v4
    v_lshrrev_b32 v5, 2, v2
    v_add_u32 v4, v4, v5
    v_lshlrev_b32 v4, 8, v4
    v_add_u32 v4, s56, v4
    v_add_u32 v5, 0, v3
    v_xor_b32 v5, v5, v2
    v_lshl_add_u32 v24, v5, 4, v4
    v_add_u32 v5, 4, v3
    v_xor_b32 v5, v5, v2
    v_lshl_add_u32 v25, v5, 4, v4
    v_add_u32 v5, 8, v3
    v_xor_b32 v5, v5, v2
    v_lshl_add_u32 v26, v5, 4, v4
    v_add_u32 v5, 12, v3
    v_xor_b32 v5, v5, v2
    v_lshl_add_u32 v27, v5, 4, v4
    v_lshlrev_b32 v28, 4, v1
    v_and_b32 v2, 15, v1
    v_lshrrev_b32 v3, 4, v1
    v_lshlrev_b32 v4, 10, v2
    v_lshl_add_u32 v4, v3, 4, v4
    s_lshl_b32 s64, s55, 7
    s_add_u32 s65, s64, 0
    buffer_load_dwordx4 v[48:51], v4, s[20:23], s65 offen
    s_add_u32 s65, s64, 64
    buffer_load_dwordx4 v[52:55], v4, s[20:23], s65 offen
    s_add_u32 s65, s64, 16384
    buffer_load_dwordx4 v[56:59], v4, s[20:23], s65 offen
    s_add_u32 s65, s64, 16448
    buffer_load_dwordx4 v[60:63], v4, s[20:23], s65 offen
    v_lshlrev_b32 v5, 16, v3
    v_lshl_add_u32 v5, v2, 1, v5
    s_lshl_b32 s66, s54, 3
    s_add_u32 s66, s66, s52
    s_lshl_b32 s66, s66, 5
    s_lshl_b32 s67, s53, 10
    s_add_u32 s66, s66, s67
    s_lshl_b32 s67, s55, 19
    s_add_u32 s67, s67, s66
    s_add_u32 s68, s67, 0x0
    buffer_load_ushort v80, v5, s[32:35], s68 offen
    s_add_u32 s68, s67, 0x2000
    buffer_load_ushort v81, v5, s[32:35], s68 offen
    s_add_u32 s68, s67, 0x4000
    buffer_load_ushort v82, v5, s[32:35], s68 offen
    s_add_u32 s68, s67, 0x6000
    buffer_load_ushort v83, v5, s[32:35], s68 offen
    s_add_u32 s68, s67, 0x8000
    buffer_load_ushort v84, v5, s[32:35], s68 offen
    s_add_u32 s68, s67, 0xa000
    buffer_load_ushort v85, v5, s[32:35], s68 offen
    s_add_u32 s68, s67, 0xc000
    buffer_load_ushort v86, v5, s[32:35], s68 offen
    s_add_u32 s68, s67, 0xe000
    buffer_load_ushort v87, v5, s[32:35], s68 offen
    s_add_u32 s68, s67, 0x40000
    buffer_load_ushort v88, v5, s[32:35], s68 offen
    s_add_u32 s68, s67, 0x42000
    buffer_load_ushort v89, v5, s[32:35], s68 offen
    s_add_u32 s68, s67, 0x44000
    buffer_load_ushort v90, v5, s[32:35], s68 offen
    s_add_u32 s68, s67, 0x46000
    buffer_load_ushort v91, v5, s[32:35], s68 offen
    s_add_u32 s68, s67, 0x48000
    buffer_load_ushort v92, v5, s[32:35], s68 offen
    s_add_u32 s68, s67, 0x4a000
    buffer_load_ushort v93, v5, s[32:35], s68 offen
    s_add_u32 s68, s67, 0x4c000
    buffer_load_ushort v94, v5, s[32:35], s68 offen
    s_add_u32 s68, s67, 0x4e000
    buffer_load_ushort v95, v5, s[32:35], s68 offen
    s_waitcnt vmcnt(0)
    v_lshl_or_b32 v64, v81, 16, v80
    v_lshl_or_b32 v65, v83, 16, v82
    v_lshl_or_b32 v66, v85, 16, v84
    v_lshl_or_b32 v67, v87, 16, v86
    v_lshl_or_b32 v68, v89, 16, v88
    v_lshl_or_b32 v69, v91, 16, v90
    v_lshl_or_b32 v70, v93, 16, v92
    v_lshl_or_b32 v71, v95, 16, v94
    s_nop 1
    v_mfma_f32_16x16x32_bf16 v[72:75], v[48:51], v[64:67], 0
    v_mfma_f32_16x16x32_bf16 v[72:75], v[52:55], v[68:71], v[72:75]
    v_mfma_f32_16x16x32_bf16 v[76:79], v[56:59], v[64:67], 0
    v_mfma_f32_16x16x32_bf16 v[76:79], v[60:63], v[68:71], v[76:79]
    s_lshl_b32 s69, s55, 11
    s_add_u32 s69, s69, 0
    v_lshl_add_u32 v6, v1, 4, s69
    s_nop 7
    s_nop 1
    ds_write_b128 v6, v[72:75] offset:0
    ds_write_b128 v6, v[76:79] offset:1024
    s_waitcnt lgkmcnt(0)
    s_barrier
    s_cmp_ge_u32 s55, 2
    s_cbranch_scc1 L_END1
    s_lshl_b32 s69, s55, 10
    s_add_u32 s69, s69, 0
    v_lshl_add_u32 v6, v1, 4, s69
    ds_read_b128 v[80:83], v6 offset:0
    ds_read_b128 v[84:87], v6 offset:2048
    ds_read_b128 v[88:91], v6 offset:4096
    ds_read_b128 v[92:95], v6 offset:6144
    ds_read_b128 v[96:99], v6 offset:8192
    ds_read_b128 v[100:103], v6 offset:10240
    ds_read_b128 v[104:107], v6 offset:12288
    ds_read_b128 v[108:111], v6 offset:14336
    s_waitcnt lgkmcnt(0)
    v_add_f32 v80, v80, v84
    v_add_f32 v81, v81, v85
    v_add_f32 v82, v82, v86
    v_add_f32 v83, v83, v87
    v_add_f32 v80, v80, v88
    v_add_f32 v81, v81, v89
    v_add_f32 v82, v82, v90
    v_add_f32 v83, v83, v91
    v_add_f32 v80, v80, v92
    v_add_f32 v81, v81, v93
    v_add_f32 v82, v82, v94
    v_add_f32 v83, v83, v95
    v_add_f32 v80, v80, v96
    v_add_f32 v81, v81, v97
    v_add_f32 v82, v82, v98
    v_add_f32 v83, v83, v99
    v_add_f32 v80, v80, v100
    v_add_f32 v81, v81, v101
    v_add_f32 v82, v82, v102
    v_add_f32 v83, v83, v103
    v_add_f32 v80, v80, v104
    v_add_f32 v81, v81, v105
    v_add_f32 v82, v82, v106
    v_add_f32 v83, v83, v107
    v_add_f32 v80, v80, v108
    v_add_f32 v81, v81, v109
    v_add_f32 v82, v82, v110
    v_add_f32 v83, v83, v111
    v_cvt_pk_bf16_f32 v84, v80, v81
    v_cvt_pk_bf16_f32 v85, v82, v83
    v_and_b32 v2, 15, v1
    v_lshrrev_b32 v3, 4, v1
    v_lshlrev_b32 v4, 15, v3
    v_lshl_add_u32 v4, v2, 1, v4
    s_lshl_b32 s69, s55, 17
    s_add_u32 s69, s69, s66
    s_add_u32 s69, s69, 0
    s_add_u32 s70, s69, 0
    buffer_store_short v84, v4, s[48:51], s70 offen
    s_add_u32 s70, s69, 8192
    buffer_store_short_d16_hi v84, v4, s[48:51], s70 offen
    s_add_u32 s70, s69, 16384
    buffer_store_short v85, v4, s[48:51], s70 offen
    s_add_u32 s70, s69, 24576
    buffer_store_short_d16_hi v85, v4, s[48:51], s70 offen
    v_mov_b32 v88, -1
    v_mov_b32 v89, -1
    v_mov_b32 v90, -1
    v_mov_b32 v91, -1
    v_lshlrev_b32 v5, 4, v1
    s_mul_i32 s69, s55, 6144
    s_add_u32 s69, s69, s58
    s_add_u32 s70, s69, 4096
    buffer_store_dwordx4 v[88:91], v5, s[48:51], s69 offen offset:0
    buffer_store_dwordx4 v[88:91], v5, s[48:51], s69 offen offset:1024
    buffer_store_dwordx4 v[88:91], v5, s[48:51], s69 offen offset:2048
    buffer_store_dwordx4 v[88:91], v5, s[48:51], s69 offen offset:3072
    buffer_store_dwordx4 v[88:91], v5, s[48:51], s70 offen offset:0
    buffer_store_dwordx4 v[88:91], v5, s[48:51], s70 offen offset:1024
L_END1:
    s_endpgm
.globl standalone__gqa_block_cached__sampling_kernel
.p2align 8
.type standalone__gqa_block_cached__sampling_kernel,@function
standalone__gqa_block_cached__sampling_kernel:
    s_load_dwordx16 s[4:19], s[0:1], 0
    s_cmp_ge_u32 s2, 256
    s_cbranch_scc1 L_END
    s_lshr_b32 s52, s2, 5
    s_lshr_b32 s53, s2, 2
    s_and_b32 s53, s53, 7
    s_and_b32 s54, s2, 3
    v_and_b32 v1, 63, v0
    v_lshrrev_b32 v2, 6, v0
    s_nop 0
    v_readfirstlane_b32 s55, v2
    s_lshl_b32 s56, s55, 14
    s_lshl_b32 s64, s52, 3
    s_add_u32 s64, s64, s53
    s_lshl_b32 s64, s64, 20
    s_lshl_b32 s65, s54, 18
    s_add_u32 s57, s64, s65
    s_mul_i32 s58, s2, 12288
    s_add_u32 s58, s58, 0x100000
    s_mov_b32 s60, 0x3e0293ee
    s_mov_b32 s61, 0xbe0293ee
    s_mov_b32 s62, 0x05040100
    s_mov_b32 s63, 0x07060302
    s_waitcnt lgkmcnt(0)
    s_mov_b32 s20, s4
    s_mov_b32 s21, s5
    s_mov_b32 s22, 0x8000
    s_mov_b32 s23, 0x00020000
    s_mov_b32 s24, s6
    s_mov_b32 s25, s7
    s_mov_b32 s26, 0x4000000
    s_mov_b32 s27, 0x00020000
    s_mov_b32 s28, s8
    s_mov_b32 s29, s9
    s_mov_b32 s30, 0x4000000
    s_mov_b32 s31, 0x00020000
    s_mov_b32 s32, s10
    s_mov_b32 s33, s11
    s_mov_b32 s34, 0x400000
    s_mov_b32 s35, 0x00020000
    s_mov_b32 s36, s12
    s_mov_b32 s37, s13
    s_mov_b32 s38, 0x400000
    s_mov_b32 s39, 0x00020000
    s_mov_b32 s40, s14
    s_mov_b32 s41, s15
    s_mov_b32 s42, 0x8000
    s_mov_b32 s43, 0x00020000
    s_mov_b32 s44, s16
    s_mov_b32 s45, s17
    s_mov_b32 s46, 0x100
    s_mov_b32 s47, 0x00020000
    s_mov_b32 s48, s18
    s_mov_b32 s49, s19
    s_mov_b32 s50, 0x10000000
    s_mov_b32 s51, 0x00020000
    v_and_b32 v2, 15, v1
    v_lshrrev_b32 v3, 4, v1
    v_lshlrev_b32 v4, 2, v3
    v_add_u32 v4, 0, v4
    v_xor_b32 v4, v4, v2
    v_lshlrev_b32 v4, 4, v4
    v_lshl_add_u32 v20, v3, 8, v4
    v_lshlrev_b32 v4, 2, v3
    v_add_u32 v4, 1, v4
    v_xor_b32 v4, v4, v2
    v_lshlrev_b32 v4, 4, v4
    v_lshl_add_u32 v21, v3, 8, v4
    v_lshlrev_b32 v4, 2, v3
    v_add_u32 v4, 2, v4
    v_xor_b32 v4, v4, v2
    v_lshlrev_b32 v4, 4, v4
    v_lshl_add_u32 v22, v3, 8, v4
    v_lshlrev_b32 v4, 2, v3
    v_add_u32 v4, 3, v4
    v_xor_b32 v4, v4, v2
    v_lshlrev_b32 v4, 4, v4
    v_lshl_add_u32 v23, v3, 8, v4
    v_and_b32 v4, 3, v2
    v_lshlrev_b32 v4, 2, v4
    v_lshrrev_b32 v5, 2, v2
    v_add_u32 v4, v4, v5
    v_lshlrev_b32 v4, 8, v4
    v_add_u32 v4, s56, v4
    v_add_u32 v5, 0, v3
    v_xor_b32 v5, v5, v2
    v_lshl_add_u32 v24, v5, 4, v4
    v_add_u32 v5, 4, v3
    v_xor_b32 v5, v5, v2
    v_lshl_add_u32 v25, v5, 4, v4
    v_add_u32 v5, 8, v3
    v_xor_b32 v5, v5, v2
    v_lshl_add_u32 v26, v5, 4, v4
    v_add_u32 v5, 12, v3
    v_xor_b32 v5, v5, v2
    v_lshl_add_u32 v27, v5, 4, v4
    v_lshlrev_b32 v28, 4, v1
    v_and_b32 v2, 3, v1
    v_lshlrev_b32 v2, 13, v2
    v_and_b32 v3, 15, v1
    v_lshrrev_b32 v3, 2, v3
    v_lshl_add_u32 v2, v3, 8, v2
    v_lshrrev_b32 v3, 4, v1
    v_lshl_add_u32 v2, v3, 4, v2
    s_lshl_b32 s69, s52, 15
    s_lshl_b32 s70, s53, 10
    s_add_u32 s69, s69, s70
    s_add_u32 s69, s69, 0
    buffer_load_dwordx4 v[32:35], v2, s[48:51], s69 offen offset:0
    buffer_load_dwordx4 v[36:39], v2, s[48:51], s69 offen offset:64
    buffer_load_dwordx4 v[40:43], v2, s[48:51], s69 offen offset:128
    buffer_load_dwordx4 v[44:47], v2, s[48:51], s69 offen offset:192
    s_lshl_b32 s64, s55, 13
    s_add_u32 s64, s64, s57
    s_add_u32 s65, s64, 4096
    s_add_u32 m0, s56, 0
    s_nop 0
    buffer_load_dwordx4 v20, s[24:27], s64 offen offset:0 nt lds
    buffer_load_dwordx4 v21, s[24:27], s64 offen offset:1024 nt lds
    buffer_load_dwordx4 v22, s[24:27], s64 offen offset:2048 nt lds
    buffer_load_dwordx4 v23, s[24:27], s64 offen offset:3072 nt lds
    s_add_u32 m0, s56, 4096
    s_nop 0
    buffer_load_dwordx4 v20, s[24:27], s65 offen offset:0 nt lds
    buffer_load_dwordx4 v21, s[24:27], s65 offen offset:1024 nt lds
    buffer_load_dwordx4 v22, s[24:27], s65 offen offset:2048 nt lds
    buffer_load_dwordx4 v23, s[24:27], s65 offen offset:3072 nt lds
    s_lshl_b32 s64, s55, 13
    s_add_u32 s64, s64, s57
    s_add_u32 s65, s64, 4096
    buffer_load_dwordx4 v[112:115], v28, s[28:31], s64 offen offset:0 nt
    buffer_load_dwordx4 v[116:119], v28, s[28:31], s64 offen offset:1024 nt
    buffer_load_dwordx4 v[120:123], v28, s[28:31], s64 offen offset:2048 nt
    buffer_load_dwordx4 v[124:127], v28, s[28:31], s64 offen offset:3072 nt
    buffer_load_dwordx4 v[128:131], v28, s[28:31], s65 offen offset:0 nt
    buffer_load_dwordx4 v[132:135], v28, s[28:31], s65 offen offset:1024 nt
    buffer_load_dwordx4 v[136:139], v28, s[28:31], s65 offen offset:2048 nt
    buffer_load_dwordx4 v[140:143], v28, s[28:31], s65 offen offset:3072 nt
    s_lshl_b32 s64, s55, 13
    s_add_u32 s64, s64, s57
    s_add_u32 s64, s64, 0x10000
    s_add_u32 s65, s64, 4096
    s_add_u32 m0, s56, 8192
    s_nop 0
    buffer_load_dwordx4 v20, s[24:27], s64 offen offset:0 nt lds
    buffer_load_dwordx4 v21, s[24:27], s64 offen offset:1024 nt lds
    buffer_load_dwordx4 v22, s[24:27], s64 offen offset:2048 nt lds
    buffer_load_dwordx4 v23, s[24:27], s64 offen offset:3072 nt lds
    s_add_u32 m0, s56, 12288
    s_nop 0
    buffer_load_dwordx4 v20, s[24:27], s65 offen offset:0 nt lds
    buffer_load_dwordx4 v21, s[24:27], s65 offen offset:1024 nt lds
    buffer_load_dwordx4 v22, s[24:27], s65 offen offset:2048 nt lds
    buffer_load_dwordx4 v23, s[24:27], s65 offen offset:3072 nt lds
    s_lshl_b32 s64, s55, 13
    s_add_u32 s64, s64, s57
    s_add_u32 s64, s64, 0x10000
    s_add_u32 s65, s64, 4096
    buffer_load_dwordx4 v[156:159], v28, s[28:31], s64 offen offset:0 nt
    buffer_load_dwordx4 v[160:163], v28, s[28:31], s64 offen offset:1024 nt
    buffer_load_dwordx4 v[164:167], v28, s[28:31], s64 offen offset:2048 nt
    buffer_load_dwordx4 v[168:171], v28, s[28:31], s64 offen offset:3072 nt
    buffer_load_dwordx4 v[172:175], v28, s[28:31], s65 offen offset:0 nt
    buffer_load_dwordx4 v[176:179], v28, s[28:31], s65 offen offset:1024 nt
    buffer_load_dwordx4 v[180:183], v28, s[28:31], s65 offen offset:2048 nt
    buffer_load_dwordx4 v[184:187], v28, s[28:31], s65 offen offset:3072 nt
    s_waitcnt vmcnt(32)
    v_mov_b32 v30, 0xff800000
    v_mov_b32 v31, 0
    v_mov_b32 v48, 0
    v_mov_b32 v49, 0
    v_mov_b32 v50, 0
    v_mov_b32 v51, 0
    v_mov_b32 v52, 0
    v_mov_b32 v53, 0
    v_mov_b32 v54, 0
    v_mov_b32 v55, 0
    v_mov_b32 v56, 0
    v_mov_b32 v57, 0
    v_mov_b32 v58, 0
    v_mov_b32 v59, 0
    v_mov_b32 v60, 0
    v_mov_b32 v61, 0
    v_mov_b32 v62, 0
    v_mov_b32 v63, 0
    v_mov_b32 v64, 0
    v_mov_b32 v65, 0
    v_mov_b32 v66, 0
    v_mov_b32 v67, 0
    v_mov_b32 v68, 0
    v_mov_b32 v69, 0
    v_mov_b32 v70, 0
    v_mov_b32 v71, 0
    v_mov_b32 v72, 0
    v_mov_b32 v73, 0
    v_mov_b32 v74, 0
    v_mov_b32 v75, 0
    v_mov_b32 v76, 0
    v_mov_b32 v77, 0
    v_mov_b32 v78, 0
    v_mov_b32 v79, 0
    s_waitcnt vmcnt(24)
    ds_read_b128 v[80:83], v24 offset:0
    ds_read_b128 v[84:87], v25 offset:0
    ds_read_b128 v[88:91], v26 offset:0
    ds_read_b128 v[92:95], v27 offset:0
    ds_read_b128 v[96:99], v24 offset:4096
    ds_read_b128 v[100:103], v25 offset:4096
    ds_read_b128 v[104:107], v26 offset:4096
    ds_read_b128 v[108:111], v27 offset:4096
    s_waitcnt lgkmcnt(0)
    s_lshl_b32 s64, s55, 13
    s_add_u32 s64, s64, s57
    s_add_u32 s64, s64, 0x20000
    s_add_u32 s65, s64, 4096
    s_add_u32 m0, s56, 0
    s_nop 0
    buffer_load_dwordx4 v20, s[24:27], s64 offen offset:0 nt lds
    buffer_load_dwordx4 v21, s[24:27], s64 offen offset:1024 nt lds
    buffer_load_dwordx4 v22, s[24:27], s64 offen offset:2048 nt lds
    buffer_load_dwordx4 v23, s[24:27], s64 offen offset:3072 nt lds
    s_add_u32 m0, s56, 4096
    s_nop 0
    buffer_load_dwordx4 v20, s[24:27], s65 offen offset:0 nt lds
    buffer_load_dwordx4 v21, s[24:27], s65 offen offset:1024 nt lds
    buffer_load_dwordx4 v22, s[24:27], s65 offen offset:2048 nt lds
    buffer_load_dwordx4 v23, s[24:27], s65 offen offset:3072 nt lds
    v_mfma_f32_16x16x32_bf16 v[144:147], v[80:83], v[32:35], 0
    v_mfma_f32_16x16x32_bf16 v[144:147], v[84:87], v[36:39], v[144:147]
    v_mfma_f32_16x16x32_bf16 v[144:147], v[88:91], v[40:43], v[144:147]
    v_mfma_f32_16x16x32_bf16 v[144:147], v[92:95], v[44:47], v[144:147]
    v_mfma_f32_16x16x32_bf16 v[148:151], v[96:99], v[32:35], 0
    v_mfma_f32_16x16x32_bf16 v[148:151], v[100:103], v[36:39], v[148:151]
    v_mfma_f32_16x16x32_bf16 v[148:151], v[104:107], v[40:43], v[148:151]
    v_mfma_f32_16x16x32_bf16 v[148:151], v[108:111], v[44:47], v[148:151]
    s_nop 7
    s_nop 1
    v_max3_f32 v2, v144, v145, v146
    v_max3_f32 v2, v2, v147, v148
    v_max3_f32 v2, v2, v149, v150
    v_max_f32 v2, v2, v151
    v_mov_b32 v3, v2
    s_nop 1
    v_permlane16_swap_b32 v2, v3
    s_nop 1
    v_max_f32 v2, v2, v3
    v_mov_b32 v3, v2
    s_nop 1
    v_permlane32_swap_b32 v2, v3
    s_nop 1
    v_max_f32 v2, v2, v3
    v_max_f32 v4, v30, v2
    v_sub_f32 v5, v30, v4
    v_mul_f32 v5, s60, v5
    v_exp_f32 v5, v5
    v_mul_f32 v6, s61, v4
    v_fma_f32 v144, v144, s60, v6
    v_fma_f32 v145, v145, s60, v6
    v_fma_f32 v146, v146, s60, v6
    v_fma_f32 v147, v147, s60, v6
    v_fma_f32 v148, v148, s60, v6
    v_fma_f32 v149, v149, s60, v6
    v_fma_f32 v150, v150, s60, v6
    v_fma_f32 v151, v151, s60, v6
    v_exp_f32 v144, v144
    v_exp_f32 v145, v145
    v_exp_f32 v146, v146
    v_exp_f32 v147, v147
    v_exp_f32 v148, v148
    v_exp_f32 v149, v149
    v_exp_f32 v150, v150
    v_exp_f32 v151, v151
    v_mov_b32 v30, v4
    v_mul_f32 v31, v31, v5
    v_add_f32 v31, v31, v144
    v_add_f32 v31, v31, v145
    v_add_f32 v31, v31, v146
    v_add_f32 v31, v31, v147
    v_add_f32 v31, v31, v148
    v_add_f32 v31, v31, v149
    v_add_f32 v31, v31, v150
    v_add_f32 v31, v31, v151
    v_mul_f32 v48, v48, v5
    v_mul_f32 v49, v49, v5
    v_mul_f32 v50, v50, v5
    v_mul_f32 v51, v51, v5
    v_mul_f32 v52, v52, v5
    v_mul_f32 v53, v53, v5
    v_mul_f32 v54, v54, v5
    v_mul_f32 v55, v55, v5
    v_mul_f32 v56, v56, v5
    v_mul_f32 v57, v57, v5
    v_mul_f32 v58, v58, v5
    v_mul_f32 v59, v59, v5
    v_mul_f32 v60, v60, v5
    v_mul_f32 v61, v61, v5
    v_mul_f32 v62, v62, v5
    v_mul_f32 v63, v63, v5
    v_mul_f32 v64, v64, v5
    v_mul_f32 v65, v65, v5
    v_mul_f32 v66, v66, v5
    v_mul_f32 v67, v67, v5
    v_mul_f32 v68, v68, v5
    v_mul_f32 v69, v69, v5
    v_mul_f32 v70, v70, v5
    v_mul_f32 v71, v71, v5
    v_mul_f32 v72, v72, v5
    v_mul_f32 v73, v73, v5
    v_mul_f32 v74, v74, v5
    v_mul_f32 v75, v75, v5
    v_mul_f32 v76, v76, v5
    v_mul_f32 v77, v77, v5
    v_mul_f32 v78, v78, v5
    v_mul_f32 v79, v79, v5
    v_cvt_pk_bf16_f32 v152, v144, v145
    v_cvt_pk_bf16_f32 v153, v146, v147
    v_cvt_pk_bf16_f32 v154, v148, v149
    v_cvt_pk_bf16_f32 v155, v150, v151
    s_waitcnt vmcnt(24)
    v_perm_b32 v80, v116, v112, s62
    v_perm_b32 v81, v124, v120, s62
    v_perm_b32 v82, v132, v128, s62
    v_perm_b32 v83, v140, v136, s62
    v_perm_b32 v84, v116, v112, s63
    v_perm_b32 v85, v124, v120, s63
    v_perm_b32 v86, v132, v128, s63
    v_perm_b32 v87, v140, v136, s63
    v_perm_b32 v88, v117, v113, s62
    v_perm_b32 v89, v125, v121, s62
    v_perm_b32 v90, v133, v129, s62
    v_perm_b32 v91, v141, v137, s62
    v_perm_b32 v92, v117, v113, s63
    v_perm_b32 v93, v125, v121, s63
    v_perm_b32 v94, v133, v129, s63
    v_perm_b32 v95, v141, v137, s63
    v_perm_b32 v96, v118, v114, s62
    v_perm_b32 v97, v126, v122, s62
    v_perm_b32 v98, v134, v130, s62
    v_perm_b32 v99, v142, v138, s62
    v_perm_b32 v100, v118, v114, s63
    v_perm_b32 v101, v126, v122, s63
    v_perm_b32 v102, v134, v130, s63
    v_perm_b32 v103, v142, v138, s63
    v_perm_b32 v104, v119, v115, s62
    v_perm_b32 v105, v127, v123, s62
    v_perm_b32 v106, v135, v131, s62
    v_perm_b32 v107, v143, v139, s62
    v_perm_b32 v108, v119, v115, s63
    v_perm_b32 v109, v127, v123, s63
    v_perm_b32 v110, v135, v131, s63
    v_perm_b32 v111, v143, v139, s63
    s_lshl_b32 s64, s55, 13
    s_add_u32 s64, s64, s57
    s_add_u32 s64, s64, 0x20000
    s_add_u32 s65, s64, 4096
    buffer_load_dwordx4 v[112:115], v28, s[28:31], s64 offen offset:0 nt
    buffer_load_dwordx4 v[116:119], v28, s[28:31], s64 offen offset:1024 nt
    buffer_load_dwordx4 v[120:123], v28, s[28:31], s64 offen offset:2048 nt
    buffer_load_dwordx4 v[124:127], v28, s[28:31], s64 offen offset:3072 nt
    buffer_load_dwordx4 v[128:131], v28, s[28:31], s65 offen offset:0 nt
    buffer_load_dwordx4 v[132:135], v28, s[28:31], s65 offen offset:1024 nt
    buffer_load_dwordx4 v[136:139], v28, s[28:31], s65 offen offset:2048 nt
    buffer_load_dwordx4 v[140:143], v28, s[28:31], s65 offen offset:3072 nt
    s_nop 1
    v_mfma_f32_16x16x32_bf16 v[48:51], v[80:83], v[152:155], v[48:51]
    v_mfma_f32_16x16x32_bf16 v[52:55], v[84:87], v[152:155], v[52:55]
    v_mfma_f32_16x16x32_bf16 v[56:59], v[88:91], v[152:155], v[56:59]
    v_mfma_f32_16x16x32_bf16 v[60:63], v[92:95], v[152:155], v[60:63]
    v_mfma_f32_16x16x32_bf16 v[64:67], v[96:99], v[152:155], v[64:67]
    v_mfma_f32_16x16x32_bf16 v[68:71], v[100:103], v[152:155], v[68:71]
    v_mfma_f32_16x16x32_bf16 v[72:75], v[104:107], v[152:155], v[72:75]
    v_mfma_f32_16x16x32_bf16 v[76:79], v[108:111], v[152:155], v[76:79]
    s_waitcnt vmcnt(24)
    ds_read_b128 v[80:83], v24 offset:8192
    ds_read_b128 v[84:87], v25 offset:8192
    ds_read_b128 v[88:91], v26 offset:8192
    ds_read_b128 v[92:95], v27 offset:8192
    ds_read_b128 v[96:99], v24 offset:12288
    ds_read_b128 v[100:103], v25 offset:12288
    ds_read_b128 v[104:107], v26 offset:12288
    ds_read_b128 v[108:111], v27 offset:12288
    s_waitcnt lgkmcnt(0)
    s_lshl_b32 s64, s55, 13
    s_add_u32 s64, s64, s57
    s_add_u32 s64, s64, 0x30000
    s_add_u32 s65, s64, 4096
    s_add_u32 m0, s56, 8192
    s_nop 0
    buffer_load_dwordx4 v20, s[24:27], s64 offen offset:0 nt lds
    buffer_load_dwordx4 v21, s[24:27], s64 offen offset:1024 nt lds
    buffer_load_dwordx4 v22, s[24:27], s64 offen offset:2048 nt lds
    buffer_load_dwordx4 v23, s[24:27], s64 offen offset:3072 nt lds
    s_add_u32 m0, s56, 12288
    s_nop 0
    buffer_load_dwordx4 v20, s[24:27], s65 offen offset:0 nt lds
    buffer_load_dwordx4 v21, s[24:27], s65 offen offset:1024 nt lds
    buffer_load_dwordx4 v22, s[24:27], s65 offen offset:2048 nt lds
    buffer_load_dwordx4 v23, s[24:27], s65 offen offset:3072 nt lds
    v_mfma_f32_16x16x32_bf16 v[144:147], v[80:83], v[32:35], 0
    v_mfma_f32_16x16x32_bf16 v[144:147], v[84:87], v[36:39], v[144:147]
    v_mfma_f32_16x16x32_bf16 v[144:147], v[88:91], v[40:43], v[144:147]
    v_mfma_f32_16x16x32_bf16 v[144:147], v[92:95], v[44:47], v[144:147]
    v_mfma_f32_16x16x32_bf16 v[148:151], v[96:99], v[32:35], 0
    v_mfma_f32_16x16x32_bf16 v[148:151], v[100:103], v[36:39], v[148:151]
    v_mfma_f32_16x16x32_bf16 v[148:151], v[104:107], v[40:43], v[148:151]
    v_mfma_f32_16x16x32_bf16 v[148:151], v[108:111], v[44:47], v[148:151]
    s_nop 7
    s_nop 1
    v_max3_f32 v2, v144, v145, v146
    v_max3_f32 v2, v2, v147, v148
    v_max3_f32 v2, v2, v149, v150
    v_max_f32 v2, v2, v151
    v_mov_b32 v3, v2
    s_nop 1
    v_permlane16_swap_b32 v2, v3
    s_nop 1
    v_max_f32 v2, v2, v3
    v_mov_b32 v3, v2
    s_nop 1
    v_permlane32_swap_b32 v2, v3
    s_nop 1
    v_max_f32 v2, v2, v3
    v_max_f32 v4, v30, v2
    v_sub_f32 v5, v30, v4
    v_mul_f32 v5, s60, v5
    v_exp_f32 v5, v5
    v_mul_f32 v6, s61, v4
    v_fma_f32 v144, v144, s60, v6
    v_fma_f32 v145, v145, s60, v6
    v_fma_f32 v146, v146, s60, v6
    v_fma_f32 v147, v147, s60, v6
    v_fma_f32 v148, v148, s60, v6
    v_fma_f32 v149, v149, s60, v6
    v_fma_f32 v150, v150, s60, v6
    v_fma_f32 v151, v151, s60, v6
    v_exp_f32 v144, v144
    v_exp_f32 v145, v145
    v_exp_f32 v146, v146
    v_exp_f32 v147, v147
    v_exp_f32 v148, v148
    v_exp_f32 v149, v149
    v_exp_f32 v150, v150
    v_exp_f32 v151, v151
    v_mov_b32 v30, v4
    v_mul_f32 v31, v31, v5
    v_add_f32 v31, v31, v144
    v_add_f32 v31, v31, v145
    v_add_f32 v31, v31, v146
    v_add_f32 v31, v31, v147
    v_add_f32 v31, v31, v148
    v_add_f32 v31, v31, v149
    v_add_f32 v31, v31, v150
    v_add_f32 v31, v31, v151
    v_mul_f32 v48, v48, v5
    v_mul_f32 v49, v49, v5
    v_mul_f32 v50, v50, v5
    v_mul_f32 v51, v51, v5
    v_mul_f32 v52, v52, v5
    v_mul_f32 v53, v53, v5
    v_mul_f32 v54, v54, v5
    v_mul_f32 v55, v55, v5
    v_mul_f32 v56, v56, v5
    v_mul_f32 v57, v57, v5
    v_mul_f32 v58, v58, v5
    v_mul_f32 v59, v59, v5
    v_mul_f32 v60, v60, v5
    v_mul_f32 v61, v61, v5
    v_mul_f32 v62, v62, v5
    v_mul_f32 v63, v63, v5
    v_mul_f32 v64, v64, v5
    v_mul_f32 v65, v65, v5
    v_mul_f32 v66, v66, v5
    v_mul_f32 v67, v67, v5
    v_mul_f32 v68, v68, v5
    v_mul_f32 v69, v69, v5
    v_mul_f32 v70, v70, v5
    v_mul_f32 v71, v71, v5
    v_mul_f32 v72, v72, v5
    v_mul_f32 v73, v73, v5
    v_mul_f32 v74, v74, v5
    v_mul_f32 v75, v75, v5
    v_mul_f32 v76, v76, v5
    v_mul_f32 v77, v77, v5
    v_mul_f32 v78, v78, v5
    v_mul_f32 v79, v79, v5
    v_cvt_pk_bf16_f32 v152, v144, v145
    v_cvt_pk_bf16_f32 v153, v146, v147
    v_cvt_pk_bf16_f32 v154, v148, v149
    v_cvt_pk_bf16_f32 v155, v150, v151
    s_waitcnt vmcnt(24)
    v_perm_b32 v80, v160, v156, s62
    v_perm_b32 v81, v168, v164, s62
    v_perm_b32 v82, v176, v172, s62
    v_perm_b32 v83, v184, v180, s62
    v_perm_b32 v84, v160, v156, s63
    v_perm_b32 v85, v168, v164, s63
    v_perm_b32 v86, v176, v172, s63
    v_perm_b32 v87, v184, v180, s63
    v_perm_b32 v88, v161, v157, s62
    v_perm_b32 v89, v169, v165, s62
    v_perm_b32 v90, v177, v173, s62
    v_perm_b32 v91, v185, v181, s62
    v_perm_b32 v92, v161, v157, s63
    v_perm_b32 v93, v169, v165, s63
    v_perm_b32 v94, v177, v173, s63
    v_perm_b32 v95, v185, v181, s63
    v_perm_b32 v96, v162, v158, s62
    v_perm_b32 v97, v170, v166, s62
    v_perm_b32 v98, v178, v174, s62
    v_perm_b32 v99, v186, v182, s62
    v_perm_b32 v100, v162, v158, s63
    v_perm_b32 v101, v170, v166, s63
    v_perm_b32 v102, v178, v174, s63
    v_perm_b32 v103, v186, v182, s63
    v_perm_b32 v104, v163, v159, s62
    v_perm_b32 v105, v171, v167, s62
    v_perm_b32 v106, v179, v175, s62
    v_perm_b32 v107, v187, v183, s62
    v_perm_b32 v108, v163, v159, s63
    v_perm_b32 v109, v171, v167, s63
    v_perm_b32 v110, v179, v175, s63
    v_perm_b32 v111, v187, v183, s63
    s_lshl_b32 s64, s55, 13
    s_add_u32 s64, s64, s57
    s_add_u32 s64, s64, 0x30000
    s_add_u32 s65, s64, 4096
    buffer_load_dwordx4 v[156:159], v28, s[28:31], s64 offen offset:0 nt
    buffer_load_dwordx4 v[160:163], v28, s[28:31], s64 offen offset:1024 nt
    buffer_load_dwordx4 v[164:167], v28, s[28:31], s64 offen offset:2048 nt
    buffer_load_dwordx4 v[168:171], v28, s[28:31], s64 offen offset:3072 nt
    buffer_load_dwordx4 v[172:175], v28, s[28:31], s65 offen offset:0 nt
    buffer_load_dwordx4 v[176:179], v28, s[28:31], s65 offen offset:1024 nt
    buffer_load_dwordx4 v[180:183], v28, s[28:31], s65 offen offset:2048 nt
    buffer_load_dwordx4 v[184:187], v28, s[28:31], s65 offen offset:3072 nt
    s_nop 1
    v_mfma_f32_16x16x32_bf16 v[48:51], v[80:83], v[152:155], v[48:51]
    v_mfma_f32_16x16x32_bf16 v[52:55], v[84:87], v[152:155], v[52:55]
    v_mfma_f32_16x16x32_bf16 v[56:59], v[88:91], v[152:155], v[56:59]
    v_mfma_f32_16x16x32_bf16 v[60:63], v[92:95], v[152:155], v[60:63]
    v_mfma_f32_16x16x32_bf16 v[64:67], v[96:99], v[152:155], v[64:67]
    v_mfma_f32_16x16x32_bf16 v[68:71], v[100:103], v[152:155], v[68:71]
    v_mfma_f32_16x16x32_bf16 v[72:75], v[104:107], v[152:155], v[72:75]
    v_mfma_f32_16x16x32_bf16 v[76:79], v[108:111], v[152:155], v[76:79]
    s_waitcnt vmcnt(24)
    ds_read_b128 v[80:83], v24 offset:0
    ds_read_b128 v[84:87], v25 offset:0
    ds_read_b128 v[88:91], v26 offset:0
    ds_read_b128 v[92:95], v27 offset:0
    ds_read_b128 v[96:99], v24 offset:4096
    ds_read_b128 v[100:103], v25 offset:4096
    ds_read_b128 v[104:107], v26 offset:4096
    ds_read_b128 v[108:111], v27 offset:4096
    s_waitcnt lgkmcnt(0)
    v_mfma_f32_16x16x32_bf16 v[144:147], v[80:83], v[32:35], 0
    v_mfma_f32_16x16x32_bf16 v[144:147], v[84:87], v[36:39], v[144:147]
    v_mfma_f32_16x16x32_bf16 v[144:147], v[88:91], v[40:43], v[144:147]
    v_mfma_f32_16x16x32_bf16 v[144:147], v[92:95], v[44:47], v[144:147]
    v_mfma_f32_16x16x32_bf16 v[148:151], v[96:99], v[32:35], 0
    v_mfma_f32_16x16x32_bf16 v[148:151], v[100:103], v[36:39], v[148:151]
    v_mfma_f32_16x16x32_bf16 v[148:151], v[104:107], v[40:43], v[148:151]
    v_mfma_f32_16x16x32_bf16 v[148:151], v[108:111], v[44:47], v[148:151]
    s_nop 7
    s_nop 1
    v_max3_f32 v2, v144, v145, v146
    v_max3_f32 v2, v2, v147, v148
    v_max3_f32 v2, v2, v149, v150
    v_max_f32 v2, v2, v151
    v_mov_b32 v3, v2
    s_nop 1
    v_permlane16_swap_b32 v2, v3
    s_nop 1
    v_max_f32 v2, v2, v3
    v_mov_b32 v3, v2
    s_nop 1
    v_permlane32_swap_b32 v2, v3
    s_nop 1
    v_max_f32 v2, v2, v3
    v_max_f32 v4, v30, v2
    v_sub_f32 v5, v30, v4
    v_mul_f32 v5, s60, v5
    v_exp_f32 v5, v5
    v_mul_f32 v6, s61, v4
    v_fma_f32 v144, v144, s60, v6
    v_fma_f32 v145, v145, s60, v6
    v_fma_f32 v146, v146, s60, v6
    v_fma_f32 v147, v147, s60, v6
    v_fma_f32 v148, v148, s60, v6
    v_fma_f32 v149, v149, s60, v6
    v_fma_f32 v150, v150, s60, v6
    v_fma_f32 v151, v151, s60, v6
    v_exp_f32 v144, v144
    v_exp_f32 v145, v145
    v_exp_f32 v146, v146
    v_exp_f32 v147, v147
    v_exp_f32 v148, v148
    v_exp_f32 v149, v149
    v_exp_f32 v150, v150
    v_exp_f32 v151, v151
    v_mov_b32 v30, v4
    v_mul_f32 v31, v31, v5
    v_add_f32 v31, v31, v144
    v_add_f32 v31, v31, v145
    v_add_f32 v31, v31, v146
    v_add_f32 v31, v31, v147
    v_add_f32 v31, v31, v148
    v_add_f32 v31, v31, v149
    v_add_f32 v31, v31, v150
    v_add_f32 v31, v31, v151
    v_mul_f32 v48, v48, v5
    v_mul_f32 v49, v49, v5
    v_mul_f32 v50, v50, v5
    v_mul_f32 v51, v51, v5
    v_mul_f32 v52, v52, v5
    v_mul_f32 v53, v53, v5
    v_mul_f32 v54, v54, v5
    v_mul_f32 v55, v55, v5
    v_mul_f32 v56, v56, v5
    v_mul_f32 v57, v57, v5
    v_mul_f32 v58, v58, v5
    v_mul_f32 v59, v59, v5
    v_mul_f32 v60, v60, v5
    v_mul_f32 v61, v61, v5
    v_mul_f32 v62, v62, v5
    v_mul_f32 v63, v63, v5
    v_mul_f32 v64, v64, v5
    v_mul_f32 v65, v65, v5
    v_mul_f32 v66, v66, v5
    v_mul_f32 v67, v67, v5
    v_mul_f32 v68, v68, v5
    v_mul_f32 v69, v69, v5
    v_mul_f32 v70, v70, v5
    v_mul_f32 v71, v71, v5
    v_mul_f32 v72, v72, v5
    v_mul_f32 v73, v73, v5
    v_mul_f32 v74, v74, v5
    v_mul_f32 v75, v75, v5
    v_mul_f32 v76, v76, v5
    v_mul_f32 v77, v77, v5
    v_mul_f32 v78, v78, v5
    v_mul_f32 v79, v79, v5
    v_cvt_pk_bf16_f32 v152, v144, v145
    v_cvt_pk_bf16_f32 v153, v146, v147
    v_cvt_pk_bf16_f32 v154, v148, v149
    v_cvt_pk_bf16_f32 v155, v150, v151
    s_waitcnt vmcnt(16)
    v_perm_b32 v80, v116, v112, s62
    v_perm_b32 v81, v124, v120, s62
    v_perm_b32 v82, v132, v128, s62
    v_perm_b32 v83, v140, v136, s62
    v_perm_b32 v84, v116, v112, s63
    v_perm_b32 v85, v124, v120, s63
    v_perm_b32 v86, v132, v128, s63
    v_perm_b32 v87, v140, v136, s63
    v_perm_b32 v88, v117, v113, s62
    v_perm_b32 v89, v125, v121, s62
    v_perm_b32 v90, v133, v129, s62
    v_perm_b32 v91, v141, v137, s62
    v_perm_b32 v92, v117, v113, s63
    v_perm_b32 v93, v125, v121, s63
    v_perm_b32 v94, v133, v129, s63
    v_perm_b32 v95, v141, v137, s63
    v_perm_b32 v96, v118, v114, s62
    v_perm_b32 v97, v126, v122, s62
    v_perm_b32 v98, v134, v130, s62
    v_perm_b32 v99, v142, v138, s62
    v_perm_b32 v100, v118, v114, s63
    v_perm_b32 v101, v126, v122, s63
    v_perm_b32 v102, v134, v130, s63
    v_perm_b32 v103, v142, v138, s63
    v_perm_b32 v104, v119, v115, s62
    v_perm_b32 v105, v127, v123, s62
    v_perm_b32 v106, v135, v131, s62
    v_perm_b32 v107, v143, v139, s62
    v_perm_b32 v108, v119, v115, s63
    v_perm_b32 v109, v127, v123, s63
    v_perm_b32 v110, v135, v131, s63
    v_perm_b32 v111, v143, v139, s63
    s_nop 1
    v_mfma_f32_16x16x32_bf16 v[48:51], v[80:83], v[152:155], v[48:51]
    v_mfma_f32_16x16x32_bf16 v[52:55], v[84:87], v[152:155], v[52:55]
    v_mfma_f32_16x16x32_bf16 v[56:59], v[88:91], v[152:155], v[56:59]
    v_mfma_f32_16x16x32_bf16 v[60:63], v[92:95], v[152:155], v[60:63]
    v_mfma_f32_16x16x32_bf16 v[64:67], v[96:99], v[152:155], v[64:67]
    v_mfma_f32_16x16x32_bf16 v[68:71], v[100:103], v[152:155], v[68:71]
    v_mfma_f32_16x16x32_bf16 v[72:75], v[104:107], v[152:155], v[72:75]
    v_mfma_f32_16x16x32_bf16 v[76:79], v[108:111], v[152:155], v[76:79]
    s_waitcnt vmcnt(8)
    ds_read_b128 v[80:83], v24 offset:8192
    ds_read_b128 v[84:87], v25 offset:8192
    ds_read_b128 v[88:91], v26 offset:8192
    ds_read_b128 v[92:95], v27 offset:8192
    ds_read_b128 v[96:99], v24 offset:12288
    ds_read_b128 v[100:103], v25 offset:12288
    ds_read_b128 v[104:107], v26 offset:12288
    ds_read_b128 v[108:111], v27 offset:12288
    s_waitcnt lgkmcnt(0)
    v_mfma_f32_16x16x32_bf16 v[144:147], v[80:83], v[32:35], 0
    v_mfma_f32_16x16x32_bf16 v[144:147], v[84:87], v[36:39], v[144:147]
    v_mfma_f32_16x16x32_bf16 v[144:147], v[88:91], v[40:43], v[144:147]
    v_mfma_f32_16x16x32_bf16 v[144:147], v[92:95], v[44:47], v[144:147]
    v_mfma_f32_16x16x32_bf16 v[148:151], v[96:99], v[32:35], 0
    v_mfma_f32_16x16x32_bf16 v[148:151], v[100:103], v[36:39], v[148:151]
    v_mfma_f32_16x16x32_bf16 v[148:151], v[104:107], v[40:43], v[148:151]
    v_mfma_f32_16x16x32_bf16 v[148:151], v[108:111], v[44:47], v[148:151]
    s_nop 7
    s_nop 1
    v_max3_f32 v2, v144, v145, v146
    v_max3_f32 v2, v2, v147, v148
    v_max3_f32 v2, v2, v149, v150
    v_max_f32 v2, v2, v151
    v_mov_b32 v3, v2
    s_nop 1
    v_permlane16_swap_b32 v2, v3
    s_nop 1
    v_max_f32 v2, v2, v3
    v_mov_b32 v3, v2
    s_nop 1
    v_permlane32_swap_b32 v2, v3
    s_nop 1
    v_max_f32 v2, v2, v3
    v_max_f32 v4, v30, v2
    v_sub_f32 v5, v30, v4
    v_mul_f32 v5, s60, v5
    v_exp_f32 v5, v5
    v_mul_f32 v6, s61, v4
    v_fma_f32 v144, v144, s60, v6
    v_fma_f32 v145, v145, s60, v6
    v_fma_f32 v146, v146, s60, v6
    v_fma_f32 v147, v147, s60, v6
    v_fma_f32 v148, v148, s60, v6
    v_fma_f32 v149, v149, s60, v6
    v_fma_f32 v150, v150, s60, v6
    v_fma_f32 v151, v151, s60, v6
    v_exp_f32 v144, v144
    v_exp_f32 v145, v145
    v_exp_f32 v146, v146
    v_exp_f32 v147, v147
    v_exp_f32 v148, v148
    v_exp_f32 v149, v149
    v_exp_f32 v150, v150
    v_exp_f32 v151, v151
    v_mov_b32 v30, v4
    v_mul_f32 v31, v31, v5
    v_add_f32 v31, v31, v144
    v_add_f32 v31, v31, v145
    v_add_f32 v31, v31, v146
    v_add_f32 v31, v31, v147
    v_add_f32 v31, v31, v148
    v_add_f32 v31, v31, v149
    v_add_f32 v31, v31, v150
    v_add_f32 v31, v31, v151
    v_mul_f32 v48, v48, v5
    v_mul_f32 v49, v49, v5
    v_mul_f32 v50, v50, v5
    v_mul_f32 v51, v51, v5
    v_mul_f32 v52, v52, v5
    v_mul_f32 v53, v53, v5
    v_mul_f32 v54, v54, v5
    v_mul_f32 v55, v55, v5
    v_mul_f32 v56, v56, v5
    v_mul_f32 v57, v57, v5
    v_mul_f32 v58, v58, v5
    v_mul_f32 v59, v59, v5
    v_mul_f32 v60, v60, v5
    v_mul_f32 v61, v61, v5
    v_mul_f32 v62, v62, v5
    v_mul_f32 v63, v63, v5
    v_mul_f32 v64, v64, v5
    v_mul_f32 v65, v65, v5
    v_mul_f32 v66, v66, v5
    v_mul_f32 v67, v67, v5
    v_mul_f32 v68, v68, v5
    v_mul_f32 v69, v69, v5
    v_mul_f32 v70, v70, v5
    v_mul_f32 v71, v71, v5
    v_mul_f32 v72, v72, v5
    v_mul_f32 v73, v73, v5
    v_mul_f32 v74, v74, v5
    v_mul_f32 v75, v75, v5
    v_mul_f32 v76, v76, v5
    v_mul_f32 v77, v77, v5
    v_mul_f32 v78, v78, v5
    v_mul_f32 v79, v79, v5
    v_cvt_pk_bf16_f32 v152, v144, v145
    v_cvt_pk_bf16_f32 v153, v146, v147
    v_cvt_pk_bf16_f32 v154, v148, v149
    v_cvt_pk_bf16_f32 v155, v150, v151
    s_waitcnt vmcnt(0)
    v_perm_b32 v80, v160, v156, s62
    v_perm_b32 v81, v168, v164, s62
    v_perm_b32 v82, v176, v172, s62
    v_perm_b32 v83, v184, v180, s62
    v_perm_b32 v84, v160, v156, s63
    v_perm_b32 v85, v168, v164, s63
    v_perm_b32 v86, v176, v172, s63
    v_perm_b32 v87, v184, v180, s63
    v_perm_b32 v88, v161, v157, s62
    v_perm_b32 v89, v169, v165, s62
    v_perm_b32 v90, v177, v173, s62
    v_perm_b32 v91, v185, v181, s62
    v_perm_b32 v92, v161, v157, s63
    v_perm_b32 v93, v169, v165, s63
    v_perm_b32 v94, v177, v173, s63
    v_perm_b32 v95, v185, v181, s63
    v_perm_b32 v96, v162, v158, s62
    v_perm_b32 v97, v170, v166, s62
    v_perm_b32 v98, v178, v174, s62
    v_perm_b32 v99, v186, v182, s62
    v_perm_b32 v100, v162, v158, s63
    v_perm_b32 v101, v170, v166, s63
    v_perm_b32 v102, v178, v174, s63
    v_perm_b32 v103, v186, v182, s63
    v_perm_b32 v104, v163, v159, s62
    v_perm_b32 v105, v171, v167, s62
    v_perm_b32 v106, v179, v175, s62
    v_perm_b32 v107, v187, v183, s62
    v_perm_b32 v108, v163, v159, s63
    v_perm_b32 v109, v171, v167, s63
    v_perm_b32 v110, v179, v175, s63
    v_perm_b32 v111, v187, v183, s63
    s_nop 1
    v_mfma_f32_16x16x32_bf16 v[48:51], v[80:83], v[152:155], v[48:51]
    v_mfma_f32_16x16x32_bf16 v[52:55], v[84:87], v[152:155], v[52:55]
    v_mfma_f32_16x16x32_bf16 v[56:59], v[88:91], v[152:155], v[56:59]
    v_mfma_f32_16x16x32_bf16 v[60:63], v[92:95], v[152:155], v[60:63]
    v_mfma_f32_16x16x32_bf16 v[64:67], v[96:99], v[152:155], v[64:67]
    v_mfma_f32_16x16x32_bf16 v[68:71], v[100:103], v[152:155], v[68:71]
    v_mfma_f32_16x16x32_bf16 v[72:75], v[104:107], v[152:155], v[72:75]
    v_mfma_f32_16x16x32_bf16 v[76:79], v[108:111], v[152:155], v[76:79]
    s_nop 4
    v_lshrrev_b32 v2, 4, v1
    v_lshlrev_b32 v2, 15, v2
    v_and_b32 v3, 15, v1
    v_lshl_add_u32 v2, v3, 4, v2
    s_lshl_b32 s64, s53, 9
    s_lshr_b32 s65, s55, 1
    s_lshl_b32 s65, s65, 7
    s_add_u32 s64, s64, s65
    s_and_b32 s65, s55, 1
    s_lshl_b32 s65, s65, 2
    s_add_u32 s64, s64, s65
    s_lshl_b32 s64, s64, 10
    s_lshl_b32 s65, s54, 8
    s_add_u32 s64, s64, s65
    s_add_u32 s66, s64, 0x0
    buffer_load_dwordx4 v[156:159], v2, s[36:39], s66 offen nt
    s_add_u32 s66, s64, 0x2000
    buffer_load_dwordx4 v[160:163], v2, s[36:39], s66 offen nt
    s_add_u32 s66, s64, 0x4000
    buffer_load_dwordx4 v[164:167], v2, s[36:39], s66 offen nt
    s_add_u32 s66, s64, 0x6000
    buffer_load_dwordx4 v[168:171], v2, s[36:39], s66 offen nt
    s_add_u32 s66, s64, 0x400
    buffer_load_dwordx4 v[172:175], v2, s[36:39], s66 offen nt
    s_add_u32 s66, s64, 0x2400
    buffer_load_dwordx4 v[176:179], v2, s[36:39], s66 offen nt
    s_add_u32 s66, s64, 0x4400
    buffer_load_dwordx4 v[180:183], v2, s[36:39], s66 offen nt
    s_add_u32 s66, s64, 0x6400
    buffer_load_dwordx4 v[184:187], v2, s[36:39], s66 offen nt
    s_add_u32 s66, s64, 0x800
    buffer_load_dwordx4 v[188:191], v2, s[36:39], s66 offen nt
    s_add_u32 s66, s64, 0x2800
    buffer_load_dwordx4 v[192:195], v2, s[36:39], s66 offen nt
    s_add_u32 s66, s64, 0x4800
    buffer_load_dwordx4 v[196:199], v2, s[36:39], s66 offen nt
    s_add_u32 s66, s64, 0x6800
    buffer_load_dwordx4 v[200:203], v2, s[36:39], s66 offen nt
    s_add_u32 s66, s64, 0xc00
    buffer_load_dwordx4 v[204:207], v2, s[36:39], s66 offen nt
    s_add_u32 s66, s64, 0x2c00
    buffer_load_dwordx4 v[208:211], v2, s[36:39], s66 offen nt
    s_add_u32 s66, s64, 0x4c00
    buffer_load_dwordx4 v[212:215], v2, s[36:39], s66 offen nt
    s_add_u32 s66, s64, 0x6c00
    buffer_load_dwordx4 v[216:219], v2, s[36:39], s66 offen nt
    s_lshl_b32 s64, s55, 9
    s_add_u32 s64, s64, 151552
    v_lshl_add_u32 v2, v1, 3, s64
    ds_write_b64 v2, v[30:31]
    v_lshl_add_u32 v3, v1, 4, s56
    s_nop 7
    s_nop 1
    ds_write_b128 v3, v[48:51] offset:0
    ds_write_b128 v3, v[52:55] offset:1024
    ds_write_b128 v3, v[56:59] offset:2048
    ds_write_b128 v3, v[60:63] offset:3072
    ds_write_b128 v3, v[64:67] offset:4096
    ds_write_b128 v3, v[68:71] offset:5120
    ds_write_b128 v3, v[72:75] offset:6144
    ds_write_b128 v3, v[76:79] offset:7168
    s_waitcnt lgkmcnt(0)
    s_barrier
    v_lshlrev_b32 v2, 3, v1
    v_add_u32 v2, 151552, v2
    ds_read_b64 v[80:81], v2 offset:0
    ds_read_b64 v[82:83], v2 offset:512
    ds_read_b64 v[84:85], v2 offset:1024
    ds_read_b64 v[86:87], v2 offset:1536
    ds_read_b64 v[88:89], v2 offset:2048
    ds_read_b64 v[90:91], v2 offset:2560
    ds_read_b64 v[92:93], v2 offset:3072
    ds_read_b64 v[94:95], v2 offset:3584
    s_lshl_b32 s64, s55, 10
    v_lshl_add_u32 v3, v1, 4, s64
    v_add_u32 v4, 0x10000, v3
    ds_read_b128 v[112:115], v3 offset:0
    ds_read_b128 v[116:119], v3 offset:16384
    ds_read_b128 v[120:123], v3 offset:32768
    ds_read_b128 v[124:127], v3 offset:49152
    ds_read_b128 v[128:131], v4 offset:0
    ds_read_b128 v[132:135], v4 offset:16384
    ds_read_b128 v[136:139], v4 offset:32768
    ds_read_b128 v[140:143], v4 offset:49152
    s_waitcnt lgkmcnt(0)
    v_max3_f32 v5, v80, v82, v84
    v_max3_f32 v5, v5, v86, v88
    v_max3_f32 v5, v5, v90, v92
    v_max_f32 v5, v5, v94
    v_sub_f32 v220, v80, v5
    v_mul_f32 v220, s60, v220
    v_exp_f32 v220, v220
    v_sub_f32 v221, v82, v5
    v_mul_f32 v221, s60, v221
    v_exp_f32 v221, v221
    v_sub_f32 v222, v84, v5
    v_mul_f32 v222, s60, v222
    v_exp_f32 v222, v222
    v_sub_f32 v223, v86, v5
    v_mul_f32 v223, s60, v223
    v_exp_f32 v223, v223
    v_sub_f32 v224, v88, v5
    v_mul_f32 v224, s60, v224
    v_exp_f32 v224, v224
    v_sub_f32 v225, v90, v5
    v_mul_f32 v225, s60, v225
    v_exp_f32 v225, v225
    v_sub_f32 v226, v92, v5
    v_mul_f32 v226, s60, v226
    v_exp_f32 v226, v226
    v_sub_f32 v227, v94, v5
    v_mul_f32 v227, s60, v227
    v_exp_f32 v227, v227
    s_nop 0
    v_mul_f32 v6, v220, v81
    v_fma_f32 v6, v221, v83, v6
    v_fma_f32 v6, v222, v85, v6
    v_fma_f32 v6, v223, v87, v6
    v_fma_f32 v6, v224, v89, v6
    v_fma_f32 v6, v225, v91, v6
    v_fma_f32 v6, v226, v93, v6
    v_fma_f32 v6, v227, v95, v6
    v_mov_b32 v7, v6
    s_nop 1
    v_permlane16_swap_b32 v6, v7
    s_nop 1
    v_add_f32 v6, v6, v7
    v_mov_b32 v7, v6
    s_nop 1
    v_permlane32_swap_b32 v6, v7
    s_nop 1
    v_add_f32 v6, v6, v7
    v_mul_f32 v228, v220, v112
    v_mul_f32 v229, v220, v113
    v_mul_f32 v230, v220, v114
    v_mul_f32 v231, v220, v115
    v_fma_f32 v228, v221, v116, v228
    v_fma_f32 v229, v221, v117, v229
    v_fma_f32 v230, v221, v118, v230
    v_fma_f32 v231, v221, v119, v231
    v_fma_f32 v228, v222, v120, v228
    v_fma_f32 v229, v222, v121, v229
    v_fma_f32 v230, v222, v122, v230
    v_fma_f32 v231, v222, v123, v231
    v_fma_f32 v228, v223, v124, v228
    v_fma_f32 v229, v223, v125, v229
    v_fma_f32 v230, v223, v126, v230
    v_fma_f32 v231, v223, v127, v231
    v_fma_f32 v228, v224, v128, v228
    v_fma_f32 v229, v224, v129, v229
    v_fma_f32 v230, v224, v130, v230
    v_fma_f32 v231, v224, v131, v231
    v_fma_f32 v228, v225, v132, v228
    v_fma_f32 v229, v225, v133, v229
    v_fma_f32 v230, v225, v134, v230
    v_fma_f32 v231, v225, v135, v231
    v_fma_f32 v228, v226, v136, v228
    v_fma_f32 v229, v226, v137, v229
    v_fma_f32 v230, v226, v138, v230
    v_fma_f32 v231, v226, v139, v231
    v_fma_f32 v228, v227, v140, v228
    v_fma_f32 v229, v227, v141, v229
    v_fma_f32 v230, v227, v142, v230
    v_fma_f32 v231, v227, v143, v231
    v_min_u32 v228, -2, v228
    v_min_u32 v229, -2, v229
    v_min_u32 v230, -2, v230
    v_min_u32 v231, -2, v231
    s_lshl_b32 s64, s55, 10
    s_add_u32 s64, s64, s58
    buffer_store_dwordx4 v[228:231], v28, s[48:51], s64 offen sc1
    s_cmp_lg_u32 s55, 0
    s_cbranch_scc1 L_T1_NOSTAT
    v_min_u32 v232, -2, v5
    v_min_u32 v233, -2, v6
    v_lshlrev_b32 v2, 3, v1
    s_add_u32 s64, s58, 8192
    s_mov_b64 s[82:83], exec
    s_mov_b64 exec, 0xffff
    buffer_store_dwordx2 v[232:233], v2, s[48:51], s64 offen sc1
    s_mov_b64 exec, s[82:83]
L_T1_NOSTAT:
    v_lshrrev_b32 v2, 4, v1
    v_and_b32 v3, 3, v1
    v_lshl_add_u32 v2, v2, 4, v3
    v_lshlrev_b32 v2, 4, v2
    v_lshlrev_b32 v3, 3, v3
    s_and_b32 s64, s2, 0xfc
    s_mul_i32 s64, s64, 12288
    s_add_u32 s64, s64, 0x100000
    s_lshr_b32 s65, s55, 1
    s_and_b32 s66, s55, 1
    s_lshl_b32 s67, s65, 6
    s_lshl_b32 s68, s66, 12
    s_add_u32 s67, s67, s68
    s_lshl_b32 s68, s65, 5
    s_add_u32 s68, s68, 8192
    s_add_u32 s72, s64, 0
    s_add_u32 s76, s72, s68
    s_add_u32 s72, s72, s67
    s_add_u32 s73, s64, 12288
    s_add_u32 s77, s73, s68
    s_add_u32 s73, s73, s67
    s_add_u32 s74, s64, 24576
    s_add_u32 s78, s74, s68
    s_add_u32 s74, s74, s67
    s_add_u32 s75, s64, 36864
    s_add_u32 s79, s75, s68
    s_add_u32 s75, s75, s67
    s_mov_b32 s80, 0
L_T3_RETRY:
    buffer_load_dwordx4 v[112:115], v2, s[48:51], s72 offen offset:0 sc1
    buffer_load_dwordx4 v[116:119], v2, s[48:51], s72 offen offset:1024 sc1
    buffer_load_dwordx4 v[120:123], v2, s[48:51], s72 offen offset:2048 sc1
    buffer_load_dwordx4 v[124:127], v2, s[48:51], s72 offen offset:3072 sc1
    buffer_load_dwordx2 v[220:221], v3, s[48:51], s76 offen sc1
    buffer_load_dwordx4 v[128:131], v2, s[48:51], s73 offen offset:0 sc1
    buffer_load_dwordx4 v[132:135], v2, s[48:51], s73 offen offset:1024 sc1
    buffer_load_dwordx4 v[136:139], v2, s[48:51], s73 offen offset:2048 sc1
    buffer_load_dwordx4 v[140:143], v2, s[48:51], s73 offen offset:3072 sc1
    buffer_load_dwordx2 v[222:223], v3, s[48:51], s77 offen sc1
    buffer_load_dwordx4 v[80:83], v2, s[48:51], s74 offen offset:0 sc1
    buffer_load_dwordx4 v[84:87], v2, s[48:51], s74 offen offset:1024 sc1
    buffer_load_dwordx4 v[88:91], v2, s[48:51], s74 offen offset:2048 sc1
    buffer_load_dwordx4 v[92:95], v2, s[48:51], s74 offen offset:3072 sc1
    buffer_load_dwordx2 v[224:225], v3, s[48:51], s78 offen sc1
    buffer_load_dwordx4 v[96:99], v2, s[48:51], s75 offen offset:0 sc1
    buffer_load_dwordx4 v[100:103], v2, s[48:51], s75 offen offset:1024 sc1
    buffer_load_dwordx4 v[104:107], v2, s[48:51], s75 offen offset:2048 sc1
    buffer_load_dwordx4 v[108:111], v2, s[48:51], s75 offen offset:3072 sc1
    buffer_load_dwordx2 v[226:227], v3, s[48:51], s79 offen sc1
    s_waitcnt vmcnt(0)
    v_max3_u32 v4, v112, v113, v114
    v_max3_u32 v4, v4, v115, v116
    v_max3_u32 v4, v4, v117, v118
    v_max3_u32 v4, v4, v119, v120
    v_max3_u32 v4, v4, v121, v122
    v_max3_u32 v4, v4, v123, v124
    v_max3_u32 v4, v4, v125, v126
    v_max3_u32 v4, v4, v127, v128
    v_max3_u32 v4, v4, v129, v130
    v_max3_u32 v4, v4, v131, v132
    v_max3_u32 v4, v4, v133, v134
    v_max3_u32 v4, v4, v135, v136
    v_max3_u32 v4, v4, v137, v138
    v_max3_u32 v4, v4, v139, v140
    v_max3_u32 v4, v4, v141, v142
    v_max3_u32 v4, v4, v143, v80
    v_max3_u32 v4, v4, v81, v82
    v_max3_u32 v4, v4, v83, v84
    v_max3_u32 v4, v4, v85, v86
    v_max3_u32 v4, v4, v87, v88
    v_max3_u32 v4, v4, v89, v90
    v_max3_u32 v4, v4, v91, v92
    v_max3_u32 v4, v4, v93, v94
    v_max3_u32 v4, v4, v95, v96
    v_max3_u32 v4, v4, v97, v98
    v_max3_u32 v4, v4, v99, v100
    v_max3_u32 v4, v4, v101, v102
    v_max3_u32 v4, v4, v103, v104
    v_max3_u32 v4, v4, v105, v106
    v_max3_u32 v4, v4, v107, v108
    v_max3_u32 v4, v4, v109, v110
    v_max3_u32 v4, v4, v111, v220
    v_max3_u32 v4, v4, v221, v222
    v_max3_u32 v4, v4, v223, v224
    v_max3_u32 v4, v4, v225, v226
    v_max_u32 v4, v4, v227
    v_cmp_eq_u32 vcc, -1, v4
    s_cbranch_vccz L_T3_OK
    s_add_u32 s80, s80, 1
    s_cmp_lt_u32 s80, 0x8000
    s_cbranch_scc0 L_T3_OK
    s_sleep 1
    s_branch L_T3_RETRY
L_T3_OK:
    v_max3_f32 v4, v220, v222, v224
    v_max_f32 v4, v4, v226
    v_sub_f32 v228, v220, v4
    v_mul_f32 v228, s60, v228
    v_exp_f32 v228, v228
    v_sub_f32 v229, v222, v4
    v_mul_f32 v229, s60, v229
    v_exp_f32 v229, v229
    v_sub_f32 v230, v224, v4
    v_mul_f32 v230, s60, v230
    v_exp_f32 v230, v230
    v_sub_f32 v231, v226, v4
    v_mul_f32 v231, s60, v231
    v_exp_f32 v231, v231
    s_nop 0
    v_mul_f32 v5, v228, v221
    v_fma_f32 v5, v229, v223, v5
    v_fma_f32 v5, v230, v225, v5
    v_fma_f32 v5, v231, v227, v5
    v_rcp_f32 v5, v5
    s_nop 0
    v_mul_f32 v228, v228, v5
    v_mul_f32 v229, v229, v5
    v_mul_f32 v230, v230, v5
    v_mul_f32 v231, v231, v5
    v_mul_f32 v232, v228, v112
    v_fma_f32 v232, v229, v128, v232
    v_fma_f32 v232, v230, v80, v232
    v_fma_f32 v232, v231, v96, v232
    v_mul_f32 v233, v228, v113
    v_fma_f32 v233, v229, v129, v233
    v_fma_f32 v233, v230, v81, v233
    v_fma_f32 v233, v231, v97, v233
    v_mul_f32 v234, v228, v114
    v_fma_f32 v234, v229, v130, v234
    v_fma_f32 v234, v230, v82, v234
    v_fma_f32 v234, v231, v98, v234
    v_mul_f32 v235, v228, v115
    v_fma_f32 v235, v229, v131, v235
    v_fma_f32 v235, v230, v83, v235
    v_fma_f32 v235, v231, v99, v235
    v_mul_f32 v236, v228, v116
    v_fma_f32 v236, v229, v132, v236
    v_fma_f32 v236, v230, v84, v236
    v_fma_f32 v236, v231, v100, v236
    v_mul_f32 v237, v228, v117
    v_fma_f32 v237, v229, v133, v237
    v_fma_f32 v237, v230, v85, v237
    v_fma_f32 v237, v231, v101, v237
    v_mul_f32 v238, v228, v118
    v_fma_f32 v238, v229, v134, v238
    v_fma_f32 v238, v230, v86, v238
    v_fma_f32 v238, v231, v102, v238
    v_mul_f32 v239, v228, v119
    v_fma_f32 v239, v229, v135, v239
    v_fma_f32 v239, v230, v87, v239
    v_fma_f32 v239, v231, v103, v239
    v_mul_f32 v240, v228, v120
    v_fma_f32 v240, v229, v136, v240
    v_fma_f32 v240, v230, v88, v240
    v_fma_f32 v240, v231, v104, v240
    v_mul_f32 v241, v228, v121
    v_fma_f32 v241, v229, v137, v241
    v_fma_f32 v241, v230, v89, v241
    v_fma_f32 v241, v231, v105, v241
    v_mul_f32 v242, v228, v122
    v_fma_f32 v242, v229, v138, v242
    v_fma_f32 v242, v230, v90, v242
    v_fma_f32 v242, v231, v106, v242
    v_mul_f32 v243, v228, v123
    v_fma_f32 v243, v229, v139, v243
    v_fma_f32 v243, v230, v91, v243
    v_fma_f32 v243, v231, v107, v243
    v_mul_f32 v244, v228, v124
    v_fma_f32 v244, v229, v140, v244
    v_fma_f32 v244, v230, v92, v244
    v_fma_f32 v244, v231, v108, v244
    v_mul_f32 v245, v228, v125
    v_fma_f32 v245, v229, v141, v245
    v_fma_f32 v245, v230, v93, v245
    v_fma_f32 v245, v231, v109, v245
    v_mul_f32 v246, v228, v126
    v_fma_f32 v246, v229, v142, v246
    v_fma_f32 v246, v230, v94, v246
    v_fma_f32 v246, v231, v110, v246
    v_mul_f32 v247, v228, v127
    v_fma_f32 v247, v229, v143, v247
    v_fma_f32 v247, v230, v95, v247
    v_fma_f32 v247, v231, v111, v247
    v_cvt_pk_bf16_f32 v144, v232, v233
    v_cvt_pk_bf16_f32 v145, v234, v235
    v_cvt_pk_bf16_f32 v146, v236, v237
    v_cvt_pk_bf16_f32 v147, v238, v239
    v_cvt_pk_bf16_f32 v148, v240, v241
    v_cvt_pk_bf16_f32 v149, v242, v243
    v_cvt_pk_bf16_f32 v150, v244, v245
    v_cvt_pk_bf16_f32 v151, v246, v247
    v_perm_b32 v80, v160, v156, s62
    v_perm_b32 v81, v168, v164, s62
    v_perm_b32 v82, v176, v172, s62
    v_perm_b32 v83, v184, v180, s62
    v_perm_b32 v84, v160, v156, s63
    v_perm_b32 v85, v168, v164, s63
    v_perm_b32 v86, v176, v172, s63
    v_perm_b32 v87, v184, v180, s63
    v_perm_b32 v88, v161, v157, s62
    v_perm_b32 v89, v169, v165, s62
    v_perm_b32 v90, v177, v173, s62
    v_perm_b32 v91, v185, v181, s62
    v_perm_b32 v92, v161, v157, s63
    v_perm_b32 v93, v169, v165, s63
    v_perm_b32 v94, v177, v173, s63
    v_perm_b32 v95, v185, v181, s63
    v_perm_b32 v96, v162, v158, s62
    v_perm_b32 v97, v170, v166, s62
    v_perm_b32 v98, v178, v174, s62
    v_perm_b32 v99, v186, v182, s62
    v_perm_b32 v100, v162, v158, s63
    v_perm_b32 v101, v170, v166, s63
    v_perm_b32 v102, v178, v174, s63
    v_perm_b32 v103, v186, v182, s63
    v_perm_b32 v104, v163, v159, s62
    v_perm_b32 v105, v171, v167, s62
    v_perm_b32 v106, v179, v175, s62
    v_perm_b32 v107, v187, v183, s62
    v_perm_b32 v108, v163, v159, s63
    v_perm_b32 v109, v171, v167, s63
    v_perm_b32 v110, v179, v175, s63
    v_perm_b32 v111, v187, v183, s63
    v_perm_b32 v112, v192, v188, s62
    v_perm_b32 v113, v200, v196, s62
    v_perm_b32 v114, v208, v204, s62
    v_perm_b32 v115, v216, v212, s62
    v_perm_b32 v116, v192, v188, s63
    v_perm_b32 v117, v200, v196, s63
    v_perm_b32 v118, v208, v204, s63
    v_perm_b32 v119, v216, v212, s63
    v_perm_b32 v120, v193, v189, s62
    v_perm_b32 v121, v201, v197, s62
    v_perm_b32 v122, v209, v205, s62
    v_perm_b32 v123, v217, v213, s62
    v_perm_b32 v124, v193, v189, s63
    v_perm_b32 v125, v201, v197, s63
    v_perm_b32 v126, v209, v205, s63
    v_perm_b32 v127, v217, v213, s63
    v_perm_b32 v128, v194, v190, s62
    v_perm_b32 v129, v202, v198, s62
    v_perm_b32 v130, v210, v206, s62
    v_perm_b32 v131, v218, v214, s62
    v_perm_b32 v132, v194, v190, s63
    v_perm_b32 v133, v202, v198, s63
    v_perm_b32 v134, v210, v206, s63
    v_perm_b32 v135, v218, v214, s63
    v_perm_b32 v136, v195, v191, s62
    v_perm_b32 v137, v203, v199, s62
    v_perm_b32 v138, v211, v207, s62
    v_perm_b32 v139, v219, v215, s62
    v_perm_b32 v140, v195, v191, s63
    v_perm_b32 v141, v203, v199, s63
    v_perm_b32 v142, v211, v207, s63
    v_perm_b32 v143, v219, v215, s63
    s_nop 1
    v_mfma_f32_16x16x32_bf16 v[48:51], v[144:147], v[80:83], 0
    v_mfma_f32_16x16x32_bf16 v[48:51], v[148:151], v[112:115], v[48:51]
    v_mfma_f32_16x16x32_bf16 v[52:55], v[144:147], v[84:87], 0
    v_mfma_f32_16x16x32_bf16 v[52:55], v[148:151], v[116:119], v[52:55]
    v_mfma_f32_16x16x32_bf16 v[56:59], v[144:147], v[88:91], 0
    v_mfma_f32_16x16x32_bf16 v[56:59], v[148:151], v[120:123], v[56:59]
    v_mfma_f32_16x16x32_bf16 v[60:63], v[144:147], v[92:95], 0
    v_mfma_f32_16x16x32_bf16 v[60:63], v[148:151], v[124:127], v[60:63]
    v_mfma_f32_16x16x32_bf16 v[64:67], v[144:147], v[96:99], 0
    v_mfma_f32_16x16x32_bf16 v[64:67], v[148:151], v[128:131], v[64:67]
    v_mfma_f32_16x16x32_bf16 v[68:71], v[144:147], v[100:103], 0
    v_mfma_f32_16x16x32_bf16 v[68:71], v[148:151], v[132:135], v[68:71]
    v_mfma_f32_16x16x32_bf16 v[72:75], v[144:147], v[104:107], 0
    v_mfma_f32_16x16x32_bf16 v[72:75], v[148:151], v[136:139], v[72:75]
    v_mfma_f32_16x16x32_bf16 v[76:79], v[144:147], v[108:111], 0
    v_mfma_f32_16x16x32_bf16 v[76:79], v[148:151], v[140:143], v[76:79]
    v_lshl_add_u32 v3, v1, 4, s56
    s_nop 7
    s_nop 1
    ds_write_b128 v3, v[48:51] offset:8192
    ds_write_b128 v3, v[52:55] offset:9216
    ds_write_b128 v3, v[56:59] offset:10240
    ds_write_b128 v3, v[60:63] offset:11264
    ds_write_b128 v3, v[64:67] offset:12288
    ds_write_b128 v3, v[68:71] offset:13312
    ds_write_b128 v3, v[72:75] offset:14336
    ds_write_b128 v3, v[76:79] offset:15360
    s_waitcnt lgkmcnt(0)
    s_barrier
    s_lshl_b32 s64, s55, 10
    s_add_u32 s64, s64, 8192
    v_lshl_add_u32 v3, v1, 4, s64
    v_add_u32 v4, 0x10000, v3
    ds_read_b128 v[112:115], v3 offset:0
    ds_read_b128 v[116:119], v3 offset:16384
    ds_read_b128 v[120:123], v3 offset:32768
    ds_read_b128 v[124:127], v3 offset:49152
    ds_read_b128 v[128:131], v4 offset:0
    ds_read_b128 v[132:135], v4 offset:16384
    ds_read_b128 v[136:139], v4 offset:32768
    ds_read_b128 v[140:143], v4 offset:49152
    s_waitcnt lgkmcnt(0)
    v_add_f32 v112, v112, v116
    v_add_f32 v113, v113, v117
    v_add_f32 v114, v114, v118
    v_add_f32 v115, v115, v119
    v_add_f32 v112, v112, v120
    v_add_f32 v113, v113, v121
    v_add_f32 v114, v114, v122
    v_add_f32 v115, v115, v123
    v_add_f32 v112, v112, v124
    v_add_f32 v113, v113, v125
    v_add_f32 v114, v114, v126
    v_add_f32 v115, v115, v127
    v_add_f32 v112, v112, v128
    v_add_f32 v113, v113, v129
    v_add_f32 v114, v114, v130
    v_add_f32 v115, v115, v131
    v_add_f32 v112, v112, v132
    v_add_f32 v113, v113, v133
    v_add_f32 v114, v114, v134
    v_add_f32 v115, v115, v135
    v_add_f32 v112, v112, v136
    v_add_f32 v113, v113, v137
    v_add_f32 v114, v114, v138
    v_add_f32 v115, v115, v139
    v_add_f32 v112, v112, v140
    v_add_f32 v113, v113, v141
    v_add_f32 v114, v114, v142
    v_add_f32 v115, v115, v143
    v_min_u32 v112, -2, v112
    v_min_u32 v113, -2, v113
    v_min_u32 v114, -2, v114
    v_min_u32 v115, -2, v115
    s_lshl_b32 s64, s55, 8
    s_add_u32 s64, s64, s58
    s_add_u32 s64, s64, 10240
    s_mov_b64 s[82:83], exec
    s_mov_b64 exec, 0xffff
    buffer_store_dwordx4 v[112:115], v28, s[48:51], s64 offen sc1
    s_mov_b64 exec, s[82:83]
    s_cmp_lg_u32 s53, s52
    s_cbranch_scc1 L_END
    s_mov_b64 exec, 0xffff
    s_lshl_b32 s64, s52, 5
    s_add_u32 s64, s64, s54
    s_mul_i32 s64, s64, 12288
    s_add_u32 s64, s64, 0x102800
    s_lshl_b32 s65, s55, 8
    s_add_u32 s64, s64, s65
    s_add_u32 s72, s64, 0x0
    s_add_u32 s73, s64, 0xc000
    s_add_u32 s74, s64, 0x18000
    s_add_u32 s75, s64, 0x24000
    s_add_u32 s76, s64, 0x30000
    s_add_u32 s77, s64, 0x3c000
    s_add_u32 s78, s64, 0x48000
    s_add_u32 s79, s64, 0x54000
    s_mov_b32 s80, 0
L_FIN_RETRY:
    buffer_load_dwordx4 v[112:115], v28, s[48:51], s72 offen sc1
    buffer_load_dwordx4 v[116:119], v28, s[48:51], s73 offen sc1
    buffer_load_dwordx4 v[120:123], v28, s[48:51], s74 offen sc1
    buffer_load_dwordx4 v[124:127], v28, s[48:51], s75 offen sc1
    buffer_load_dwordx4 v[128:131], v28, s[48:51], s76 offen sc1
    buffer_load_dwordx4 v[132:135], v28, s[48:51], s77 offen sc1
    buffer_load_dwordx4 v[136:139], v28, s[48:51], s78 offen sc1
    buffer_load_dwordx4 v[140:143], v28, s[48:51], s79 offen sc1
    s_waitcnt vmcnt(0)
    v_max3_u32 v4, v112, v113, v114
    v_max3_u32 v4, v4, v115, v116
    v_max3_u32 v4, v4, v117, v118
    v_max3_u32 v4, v4, v119, v120
    v_max3_u32 v4, v4, v121, v122
    v_max3_u32 v4, v4, v123, v124
    v_max3_u32 v4, v4, v125, v126
    v_max3_u32 v4, v4, v127, v128
    v_max3_u32 v4, v4, v129, v130
    v_max3_u32 v4, v4, v131, v132
    v_max3_u32 v4, v4, v133, v134
    v_max3_u32 v4, v4, v135, v136
    v_max3_u32 v4, v4, v137, v138
    v_max3_u32 v4, v4, v139, v140
    v_max3_u32 v4, v4, v141, v142
    v_max_u32 v4, v4, v143
    v_cmp_eq_u32 vcc, -1, v4
    s_cbranch_vccz L_FIN_OK
    s_add_u32 s80, s80, 1
    s_cmp_lt_u32 s80, 0x8000
    s_cbranch_scc0 L_FIN_OK
    s_sleep 1
    s_branch L_FIN_RETRY
L_FIN_OK:
    v_add_f32 v112, v112, v116
    v_add_f32 v113, v113, v117
    v_add_f32 v114, v114, v118
    v_add_f32 v115, v115, v119
    v_add_f32 v112, v112, v120
    v_add_f32 v113, v113, v121
    v_add_f32 v114, v114, v122
    v_add_f32 v115, v115, v123
    v_add_f32 v112, v112, v124
    v_add_f32 v113, v113, v125
    v_add_f32 v114, v114, v126
    v_add_f32 v115, v115, v127
    v_add_f32 v112, v112, v128
    v_add_f32 v113, v113, v129
    v_add_f32 v114, v114, v130
    v_add_f32 v115, v115, v131
    v_add_f32 v112, v112, v132
    v_add_f32 v113, v113, v133
    v_add_f32 v114, v114, v134
    v_add_f32 v115, v115, v135
    v_add_f32 v112, v112, v136
    v_add_f32 v113, v113, v137
    v_add_f32 v114, v114, v138
    v_add_f32 v115, v115, v139
    v_add_f32 v112, v112, v140
    v_add_f32 v113, v113, v141
    v_add_f32 v114, v114, v142
    v_add_f32 v115, v115, v143
    v_cvt_pk_bf16_f32 v116, v112, v113
    v_cvt_pk_bf16_f32 v117, v114, v115
    v_lshlrev_b32 v2, 4, v1
    s_lshl_b32 s64, s52, 12
    s_lshl_b32 s65, s54, 8
    s_add_u32 s64, s64, s65
    s_lshl_b32 s65, s55, 1
    s_add_u32 s64, s64, s65
    s_add_u32 s65, s64, 0
    buffer_store_short v116, v2, s[40:43], s65 offen
    s_add_u32 s65, s64, 1024
    buffer_store_short_d16_hi v116, v2, s[40:43], s65 offen
    s_add_u32 s65, s64, 2048
    buffer_store_short v117, v2, s[40:43], s65 offen
    s_add_u32 s65, s64, 3072
    buffer_store_short_d16_hi v117, v2, s[40:43], s65 offen
    s_mov_b64 exec, -1
L_END:
    s_endpgm
.section .rodata,"a"
.p2align 6
.amdhsa_kernel qproj_kernel
  .amdhsa_next_free_vgpr 128
  .amdhsa_next_free_sgpr 96
  .amdhsa_accum_offset 128
  .amdhsa_group_segment_fixed_size 0
  .amdhsa_kernarg_size 64
  .amdhsa_user_sgpr_count 2
  .amdhsa_user_sgpr_kernarg_segment_ptr 1
  .amdhsa_system_sgpr_workgroup_id_x 1
.end_amdhsa_kernel
.section .rodata,"a"
.p2align 6
.amdhsa_kernel standalone__gqa_block_cached__sampling_kernel
  .amdhsa_next_free_vgpr 256
  .amdhsa_next_free_sgpr 96
  .amdhsa_accum_offset 256
  .amdhsa_group_segment_fixed_size 0
  .amdhsa_kernarg_size 64
  .amdhsa_user_sgpr_count 2
  .amdhsa_user_sgpr_kernarg_segment_ptr 1
  .amdhsa_system_sgpr_workgroup_id_x 1
.end_amdhsa_kernel
```
